```python
import torch

def _softmax(x, axis=-1):
    return torch.softmax(x, dim=axis)

def _gelu(x):
    return torch.nn.functional.gelu(x, approximate='tanh')

def _silu(x):
    return torch.nn.functional.silu(x)

def _sigmoid(x):
    return torch.sigmoid(x)

def _layernorm(x, axis=-1, eps=1e-05):
    m = x.mean(dim=axis, keepdim=True)
    v = x.var(dim=axis, keepdim=True, unbiased=False)
    return (x - m) / torch.sqrt(v + eps)

def _scatter_add(tgt, idx, src, axis=0):
    return tgt.clone().index_add_(axis, idx, src)

def _segment_sum(src, seg, n):
    out = torch.zeros((n,) + src.shape[1:], dtype=src.dtype)
    return out.index_add_(0, seg, src)

def _pad(x, pw):
    flat = tuple((v for pair in reversed(pw) for v in pair))
    return torch.nn.functional.pad(x, flat)
kernel_name = 'standalone__tree_speculative_verify_tree_attention_over_candidate_token_tree__sampling'

def setup_inputs():

    _w = lambda a: (lambda t: t.to(torch.bfloat16) if t.is_floating_point() else t)(torch.as_tensor(a))
    B, Hq, Hkv, T, C, D = (16, 32, 8, 8, 2048, 128)
    tree_mask = torch.zeros((B, T, T), dtype=float)
    for b in range(B):
        parent = torch.zeros(T, dtype=torch.int64)
        for i in range(1, T):
            parent[i] = int(torch.randint(0, i, (1,)).item())
        for i in range(T):
            j = i
            tree_mask[b, i, j] = 1.0
            while j > 0:
                j = parent[j]
                tree_mask[b, i, j] = 1.0
    return {'q': _w((lambda *s: torch.randn(*s, dtype=torch.bfloat16) * 0.8)(B, Hq, T, D)), 'k_cache': _w((lambda *s: torch.randn(*s, dtype=torch.bfloat16) * 0.8)(B, Hkv, C, D)), 'v_cache': _w((lambda *s: torch.randn(*s, dtype=torch.bfloat16) * 0.05)(B, Hkv, C, D)), 'k_tree': _w((lambda *s: torch.randn(*s, dtype=torch.bfloat16) * 0.8)(B, Hkv, T, D)), 'v_tree': _w((lambda *s: torch.randn(*s, dtype=torch.bfloat16) * 0.05)(B, Hkv, T, D)), 'tree_mask': _w(tree_mask)}

def reference(q, k_cache, v_cache, k_tree, v_tree, tree_mask):
    B, Hq, T, D = q.shape
    Hkv, C = (k_cache.shape[1], k_cache.shape[2])
    rep = Hq // Hkv
    kc = (lambda x, n, axis: torch.repeat_interleave(x, n, dim=axis))(k_cache, rep, axis=1)
    vc = (lambda x, n, axis: torch.repeat_interleave(x, n, dim=axis))(v_cache, rep, axis=1)
    kt = (lambda x, n, axis: torch.repeat_interleave(x, n, dim=axis))(k_tree, rep, axis=1)
    vt = (lambda x, n, axis: torch.repeat_interleave(x, n, dim=axis))(v_tree, rep, axis=1)
    k = torch.concatenate([kc, kt], axis=2)
    v = torch.concatenate([vc, vt], axis=2)
    scale = D ** (-0.5)
    scores = torch.einsum('bhqd,bhkd->bhqk', q, k) * scale
    ctx_mask = torch.ones((B, 1, T, C), dtype=scores.dtype)
    tm = tree_mask[:, None, :, :].clone()
    full_mask = torch.concatenate([ctx_mask, tm], axis=-1)
    scores = scores + (1.0 - full_mask) * -1000000000.0
    p = _softmax(scores, axis=-1)
    return torch.einsum('bhqk,bhkd->bhqd', p, v)
```

```asm
; @launch grid=(256,1,1) block=(576,1,1) lds=157696
.amdgcn_target "amdgcn-amd-amdhsa--gfx950"
.text
.globl standalone__tree_speculative_verify_tree_attention_over_candidate_token_tree__sampling_kernel
.p2align 8
.type standalone__tree_speculative_verify_tree_attention_over_candidate_token_tree__sampling_kernel,@function
standalone__tree_speculative_verify_tree_attention_over_candidate_token_tree__sampling_kernel:
    s_load_dwordx2 s[24:25], s[0:1], 8
    s_load_dwordx2 s[32:33], s[0:1], 0
    s_load_dwordx2 s[28:29], s[0:1], 16
    s_cmpk_ge_u32 s2, 256
    s_cbranch_scc1 L_end
    v_and_b32 v1, 63, v0
    v_readfirstlane_b32 s52, v0
    v_lshlrev_b32 v4, 4, v1
    v_and_b32 v2, 48, v0
    v_xor_b32 v4, v4, v2
    v_xor_b32 v5, 64, v4
    v_xor_b32 v6, 128, v4
    v_xor_b32 v7, 64, v6
    s_lshr_b32 s58, s2, 4
    s_and_b32 s59, s2, 7
    s_lshl4_add_u32 s60, s59, s58
    s_cmp_lg_u32 s52, 0
    s_cbranch_scc1 L_consumer
    s_load_dwordx2 s[40:41], s[0:1], 24
    s_load_dwordx2 s[44:45], s[0:1], 32
    s_load_dwordx2 s[48:49], s[0:1], 40
    s_lshl_b32 s34, 1, 20
    s_mov_b32 s35, 0x20000
    s_lshl_b32 s63, s60, 13
    s_mov_b32 m0, 32768
    s_waitcnt lgkmcnt(0)
    buffer_load_dwordx4 v4, s[32:35], s63 offen offset:0  lds
    buffer_load_dwordx4 v5, s[32:35], s63 offen offset:1024  lds
    buffer_load_dwordx4 v6, s[32:35], s63 offen offset:2048  lds
    buffer_load_dwordx4 v7, s[32:35], s63 offen offset:3072  lds
    s_mov_b32 m0, 36864
    s_add_u32 s58, s63, 4096
    buffer_load_dwordx4 v4, s[32:35], s58 offen offset:0  lds
    buffer_load_dwordx4 v5, s[32:35], s58 offen offset:1024  lds
    buffer_load_dwordx4 v6, s[32:35], s58 offen offset:2048  lds
    buffer_load_dwordx4 v7, s[32:35], s58 offen offset:3072  lds
    s_bfe_u32 s61, s2, 0x10003
    s_lshl_b32 s42, 1, 18
    s_mov_b32 s43, s35
    s_mov_b64 s[46:47], s[42:43]
    s_movk_i32 s50, 2048
    s_mov_b32 s51, s35
    v_lshrrev_b32 v132, 3, v1
    v_and_b32 v133, 6, v132
    v_and_b32 v134, 7, v1
    v_xor_b32 v133, v133, v134
    v_lshlrev_b32 v133, 4, v133
    v_lshl_add_u32 v133, v132, 8, v133
    s_lshl_b32 s59, s61, 7
    v_add_u32 v8, s59, v133
    v_lshlrev_b32 v137, 2, v1
    s_lshl_b32 s4, s60, 11
    s_lshr_b32 s5, s60, 3
    s_lshl_b32 s5, s5, 7
    s_mov_b32 m0, 149504
    s_nop 0
    buffer_load_dwordx4 v4, s[40:43], s4 offen offset:0 lds
    buffer_load_dwordx4 v5, s[40:43], s4 offen offset:1024 lds
    s_mov_b32 m0, 153600
    s_nop 0
    buffer_load_dwordx4 v8, s[44:47], s4 offen lds
    s_mov_b32 m0, 155648
    s_nop 0
    buffer_load_dword v137, s[48:51], s5 offen lds
    s_lshl_b32 s54, s60, 19
    s_lshl_b32 s26, 1, 26
    s_mov_b32 s27, s35
    s_mov_b32 m0, 0
    s_nop 0
    buffer_load_dwordx4 v4, s[24:27], s54 offen offset:0 nt lds
    buffer_load_dwordx4 v5, s[24:27], s54 offen offset:1024 nt lds
    buffer_load_dwordx4 v6, s[24:27], s54 offen offset:2048 nt lds
    buffer_load_dwordx4 v7, s[24:27], s54 offen offset:3072 nt lds
    s_movk_i32 m0, 4096
    s_add_u32 s58, s54, 32768
    buffer_load_dwordx4 v4, s[24:27], s58 offen offset:0 nt lds
    buffer_load_dwordx4 v5, s[24:27], s58 offen offset:1024 nt lds
    buffer_load_dwordx4 v6, s[24:27], s58 offen offset:2048 nt lds
    buffer_load_dwordx4 v7, s[24:27], s58 offen offset:3072 nt lds
    s_movk_i32 m0, 8192
    s_add_u32 s58, s54, 4096
    buffer_load_dwordx4 v4, s[24:27], s58 offen offset:0 nt lds
    buffer_load_dwordx4 v5, s[24:27], s58 offen offset:1024 nt lds
    buffer_load_dwordx4 v6, s[24:27], s58 offen offset:2048 nt lds
    buffer_load_dwordx4 v7, s[24:27], s58 offen offset:3072 nt lds
    s_movk_i32 m0, 12288
    s_add_u32 s58, s54, 36864
    buffer_load_dwordx4 v4, s[24:27], s58 offen offset:0 nt lds
    buffer_load_dwordx4 v5, s[24:27], s58 offen offset:1024 nt lds
    buffer_load_dwordx4 v6, s[24:27], s58 offen offset:2048 nt lds
    buffer_load_dwordx4 v7, s[24:27], s58 offen offset:3072 nt lds
    s_getpc_b64 s[8:9]
L_pc2:
    s_sub_u32 s8, s8, L_pc2-standalone__tree_speculative_verify_tree_attention_over_candidate_token_tree__sampling_kernel
    s_subb_u32 s9, s9, 0
    s_lshr_b32 s10, s2, 3
    s_mul_i32 s10, s10, 192
    s_min_u32 s10, s10, L_codeend-standalone__tree_speculative_verify_tree_attention_over_candidate_token_tree__sampling_kernel-132
    s_load_dword s19, s[8:9], s10 offset:0
    s_load_dword s19, s[8:9], s10 offset:64
    s_load_dword s19, s[8:9], s10 offset:128
    v_add_u32 v9, 1024, v8
    v_add_u32 v10, 30720, v8
    v_add_u32 v11, 31744, v8
    s_mov_b32 s30, 0x4000000
    s_mov_b32 s31, 0x20000
    s_lshl_b32 s55, s60, 19
    s_setprio 3
    s_mov_b32 s56, 49152
    s_mov_b32 s53, 1
    s_waitcnt vmcnt(27)
    s_movk_i32 m0, 16384
    s_add_u32 s58, s54, 8192
    buffer_load_dwordx4 v4, s[24:27], s58 offen offset:0 nt lds
    buffer_load_dwordx4 v5, s[24:27], s58 offen offset:1024 nt lds
    buffer_load_dwordx4 v6, s[24:27], s58 offen offset:2048 nt lds
    buffer_load_dwordx4 v7, s[24:27], s58 offen offset:3072 nt lds
    s_waitcnt vmcnt(27)
    s_movk_i32 m0, 20480
    s_add_u32 s58, s54, 40960
    buffer_load_dwordx4 v4, s[24:27], s58 offen offset:0 nt lds
    buffer_load_dwordx4 v5, s[24:27], s58 offen offset:1024 nt lds
    buffer_load_dwordx4 v6, s[24:27], s58 offen offset:2048 nt lds
    buffer_load_dwordx4 v7, s[24:27], s58 offen offset:3072 nt lds
    s_waitcnt vmcnt(27)
    s_movk_i32 m0, 24576
    s_add_u32 s58, s54, 12288
    buffer_load_dwordx4 v4, s[24:27], s58 offen offset:0 nt lds
    buffer_load_dwordx4 v5, s[24:27], s58 offen offset:1024 nt lds
    buffer_load_dwordx4 v6, s[24:27], s58 offen offset:2048 nt lds
    buffer_load_dwordx4 v7, s[24:27], s58 offen offset:3072 nt lds
    s_waitcnt vmcnt(27)
    s_movk_i32 m0, 28672
    s_add_u32 s58, s54, 45056
    buffer_load_dwordx4 v4, s[24:27], s58 offen offset:0 nt lds
    buffer_load_dwordx4 v5, s[24:27], s58 offen offset:1024 nt lds
    buffer_load_dwordx4 v6, s[24:27], s58 offen offset:2048 nt lds
    buffer_load_dwordx4 v7, s[24:27], s58 offen offset:3072 nt lds
    s_or_b32 s54, s54, 45056
    s_add_u32 s54, s54, 4096
    s_andn2_b32 s54, s54, 45056
    s_waitcnt vmcnt(27)
L_ld:
    s_add_u32 s17, s56, 32768
    s_mov_b32 m0, s56
    s_nop 0
    buffer_load_dwordx4 v4, s[24:27], s54 offen offset:0 nt lds
    buffer_load_dwordx4 v5, s[24:27], s54 offen offset:1024 nt lds
    buffer_load_dwordx4 v6, s[24:27], s54 offen offset:2048 nt lds
    buffer_load_dwordx4 v7, s[24:27], s54 offen offset:3072 nt lds
    s_waitcnt vmcnt(27)
    s_add_u32 m0, s56, 4096
    s_add_u32 s58, s54, 32768
    buffer_load_dwordx4 v4, s[24:27], s58 offen offset:0 nt lds
    buffer_load_dwordx4 v5, s[24:27], s58 offen offset:1024 nt lds
    buffer_load_dwordx4 v6, s[24:27], s58 offen offset:2048 nt lds
    buffer_load_dwordx4 v7, s[24:27], s58 offen offset:3072 nt lds
    s_waitcnt vmcnt(27)
    s_mov_b32 m0, s17
    s_nop 0
    buffer_load_dwordx4 v8, s[28:31], s55 offen offset:0 nt lds
    buffer_load_dwordx4 v9, s[28:31], s55 offen offset:1024 nt lds
    buffer_load_dwordx4 v10, s[28:31], s55 offen offset:2048 nt lds
    buffer_load_dwordx4 v11, s[28:31], s55 offen offset:3072 nt lds
    s_waitcnt vmcnt(27)
    s_add_u32 m0, s56, 8192
    s_add_u32 s58, s54, 4096
    buffer_load_dwordx4 v4, s[24:27], s58 offen offset:0 nt lds
    buffer_load_dwordx4 v5, s[24:27], s58 offen offset:1024 nt lds
    buffer_load_dwordx4 v6, s[24:27], s58 offen offset:2048 nt lds
    buffer_load_dwordx4 v7, s[24:27], s58 offen offset:3072 nt lds
    s_waitcnt vmcnt(27)
    s_add_u32 m0, s56, 12288
    s_add_u32 s58, s54, 36864
    buffer_load_dwordx4 v4, s[24:27], s58 offen offset:0 nt lds
    buffer_load_dwordx4 v5, s[24:27], s58 offen offset:1024 nt lds
    buffer_load_dwordx4 v6, s[24:27], s58 offen offset:2048 nt lds
    buffer_load_dwordx4 v7, s[24:27], s58 offen offset:3072 nt lds
    s_waitcnt vmcnt(27)
    s_add_u32 m0, s17, 4096
    s_add_u32 s58, s55, 4096
    buffer_load_dwordx4 v8, s[28:31], s58 offen offset:0 nt lds
    buffer_load_dwordx4 v9, s[28:31], s58 offen offset:1024 nt lds
    buffer_load_dwordx4 v10, s[28:31], s58 offen offset:2048 nt lds
    buffer_load_dwordx4 v11, s[28:31], s58 offen offset:3072 nt lds
    s_waitcnt vmcnt(27)
    s_add_u32 m0, s56, 16384
    s_add_u32 s58, s54, 8192
    buffer_load_dwordx4 v4, s[24:27], s58 offen offset:0 nt lds
    buffer_load_dwordx4 v5, s[24:27], s58 offen offset:1024 nt lds
    buffer_load_dwordx4 v6, s[24:27], s58 offen offset:2048 nt lds
    buffer_load_dwordx4 v7, s[24:27], s58 offen offset:3072 nt lds
    s_waitcnt vmcnt(27)
    s_barrier
    s_add_u32 m0, s56, 20480
    s_add_u32 s58, s54, 40960
    buffer_load_dwordx4 v4, s[24:27], s58 offen offset:0 nt lds
    buffer_load_dwordx4 v5, s[24:27], s58 offen offset:1024 nt lds
    buffer_load_dwordx4 v6, s[24:27], s58 offen offset:2048 nt lds
    buffer_load_dwordx4 v7, s[24:27], s58 offen offset:3072 nt lds
    s_waitcnt vmcnt(27)
    s_add_u32 m0, s17, 8192
    s_add_u32 s58, s55, 8192
    buffer_load_dwordx4 v8, s[28:31], s58 offen offset:0 nt lds
    buffer_load_dwordx4 v9, s[28:31], s58 offen offset:1024 nt lds
    buffer_load_dwordx4 v10, s[28:31], s58 offen offset:2048 nt lds
    buffer_load_dwordx4 v11, s[28:31], s58 offen offset:3072 nt lds
    s_waitcnt vmcnt(27)
    s_add_u32 m0, s56, 24576
    s_add_u32 s58, s54, 12288
    buffer_load_dwordx4 v4, s[24:27], s58 offen offset:0 nt lds
    buffer_load_dwordx4 v5, s[24:27], s58 offen offset:1024 nt lds
    buffer_load_dwordx4 v6, s[24:27], s58 offen offset:2048 nt lds
    buffer_load_dwordx4 v7, s[24:27], s58 offen offset:3072 nt lds
    s_waitcnt vmcnt(27)
    s_add_u32 m0, s56, 28672
    s_add_u32 s58, s54, 45056
    buffer_load_dwordx4 v4, s[24:27], s58 offen offset:0 nt lds
    buffer_load_dwordx4 v5, s[24:27], s58 offen offset:1024 nt lds
    buffer_load_dwordx4 v6, s[24:27], s58 offen offset:2048 nt lds
    buffer_load_dwordx4 v7, s[24:27], s58 offen offset:3072 nt lds
    s_waitcnt vmcnt(27)
    s_add_u32 m0, s17, 12288
    s_add_u32 s58, s55, 12288
    buffer_load_dwordx4 v8, s[28:31], s58 offen offset:0 nt lds
    buffer_load_dwordx4 v9, s[28:31], s58 offen offset:1024 nt lds
    buffer_load_dwordx4 v10, s[28:31], s58 offen offset:2048 nt lds
    buffer_load_dwordx4 v11, s[28:31], s58 offen offset:3072 nt lds
    s_or_b32 s54, s54, 45056
    s_add_u32 s54, s54, 4096
    s_andn2_b32 s54, s54, 45056
    s_or_b32 s55, s55, 45056
    s_add_u32 s55, s55, 4096
    s_andn2_b32 s55, s55, 45056
    s_add_u32 s56, s56, 49152
    s_cmp_eq_u32 s56, 147456
    s_cselect_b32 s56, 0, s56
    s_add_u32 s53, s53, 1
    s_cmp_lt_u32 s53, 15
    s_waitcnt vmcnt(27)
    s_cbranch_scc1 L_ld
    s_mov_b32 m0, 0
    s_nop 0
    buffer_load_dwordx4 v4, s[24:27], s54 offen offset:0 nt lds
    buffer_load_dwordx4 v5, s[24:27], s54 offen offset:1024 nt lds
    buffer_load_dwordx4 v6, s[24:27], s54 offen offset:2048 nt lds
    buffer_load_dwordx4 v7, s[24:27], s54 offen offset:3072 nt lds
    s_waitcnt vmcnt(27)
    s_movk_i32 m0, 4096
    s_add_u32 s58, s54, 32768
    buffer_load_dwordx4 v4, s[24:27], s58 offen offset:0 nt lds
    buffer_load_dwordx4 v5, s[24:27], s58 offen offset:1024 nt lds
    buffer_load_dwordx4 v6, s[24:27], s58 offen offset:2048 nt lds
    buffer_load_dwordx4 v7, s[24:27], s58 offen offset:3072 nt lds
    s_waitcnt vmcnt(27)
    s_movk_i32 m0, 8192
    s_add_u32 s58, s54, 4096
    buffer_load_dwordx4 v4, s[24:27], s58 offen offset:0 nt lds
    buffer_load_dwordx4 v5, s[24:27], s58 offen offset:1024 nt lds
    buffer_load_dwordx4 v6, s[24:27], s58 offen offset:2048 nt lds
    buffer_load_dwordx4 v7, s[24:27], s58 offen offset:3072 nt lds
    s_waitcnt vmcnt(27)
    s_movk_i32 m0, 12288
    s_add_u32 s58, s54, 36864
    buffer_load_dwordx4 v4, s[24:27], s58 offen offset:0 nt lds
    buffer_load_dwordx4 v5, s[24:27], s58 offen offset:1024 nt lds
    buffer_load_dwordx4 v6, s[24:27], s58 offen offset:2048 nt lds
    buffer_load_dwordx4 v7, s[24:27], s58 offen offset:3072 nt lds
    s_waitcnt vmcnt(27)
    s_mov_b32 m0, 32768
    s_nop 0
    buffer_load_dwordx4 v8, s[28:31], s55 offen offset:0 nt lds
    buffer_load_dwordx4 v9, s[28:31], s55 offen offset:1024 nt lds
    buffer_load_dwordx4 v10, s[28:31], s55 offen offset:2048 nt lds
    buffer_load_dwordx4 v11, s[28:31], s55 offen offset:3072 nt lds
    s_waitcnt vmcnt(27)
    s_movk_i32 m0, 16384
    s_add_u32 s58, s54, 8192
    buffer_load_dwordx4 v4, s[24:27], s58 offen offset:0 nt lds
    buffer_load_dwordx4 v5, s[24:27], s58 offen offset:1024 nt lds
    buffer_load_dwordx4 v6, s[24:27], s58 offen offset:2048 nt lds
    buffer_load_dwordx4 v7, s[24:27], s58 offen offset:3072 nt lds
    s_waitcnt vmcnt(27)
    s_movk_i32 m0, 20480
    s_add_u32 s58, s54, 40960
    buffer_load_dwordx4 v4, s[24:27], s58 offen offset:0 nt lds
    buffer_load_dwordx4 v5, s[24:27], s58 offen offset:1024 nt lds
    buffer_load_dwordx4 v6, s[24:27], s58 offen offset:2048 nt lds
    buffer_load_dwordx4 v7, s[24:27], s58 offen offset:3072 nt lds
    s_waitcnt vmcnt(28)
    s_barrier
    s_waitcnt vmcnt(27)
    s_movk_i32 m0, 24576
    s_add_u32 s58, s54, 12288
    buffer_load_dwordx4 v4, s[24:27], s58 offen offset:0 nt lds
    buffer_load_dwordx4 v5, s[24:27], s58 offen offset:1024 nt lds
    buffer_load_dwordx4 v6, s[24:27], s58 offen offset:2048 nt lds
    buffer_load_dwordx4 v7, s[24:27], s58 offen offset:3072 nt lds
    s_waitcnt vmcnt(27)
    s_movk_i32 m0, 28672
    s_add_u32 s58, s54, 45056
    buffer_load_dwordx4 v4, s[24:27], s58 offen offset:0 nt lds
    buffer_load_dwordx4 v5, s[24:27], s58 offen offset:1024 nt lds
    buffer_load_dwordx4 v6, s[24:27], s58 offen offset:2048 nt lds
    buffer_load_dwordx4 v7, s[24:27], s58 offen offset:3072 nt lds
    s_waitcnt vmcnt(20)
    s_mov_b32 m0, 36864
    s_add_u32 s58, s55, 4096
    buffer_load_dwordx4 v8, s[28:31], s58 offen offset:0 nt lds
    buffer_load_dwordx4 v9, s[28:31], s58 offen offset:1024 nt lds
    buffer_load_dwordx4 v10, s[28:31], s58 offen offset:2048 nt lds
    buffer_load_dwordx4 v11, s[28:31], s58 offen offset:3072 nt lds
    s_waitcnt vmcnt(20)
    s_mov_b32 m0, 40960
    s_add_u32 s58, s55, 8192
    buffer_load_dwordx4 v8, s[28:31], s58 offen offset:0 nt lds
    buffer_load_dwordx4 v9, s[28:31], s58 offen offset:1024 nt lds
    buffer_load_dwordx4 v10, s[28:31], s58 offen offset:2048 nt lds
    buffer_load_dwordx4 v11, s[28:31], s58 offen offset:3072 nt lds
    s_waitcnt vmcnt(20)
    s_mov_b32 m0, 45056
    s_add_u32 s58, s55, 12288
    buffer_load_dwordx4 v8, s[28:31], s58 offen offset:0 nt lds
    buffer_load_dwordx4 v9, s[28:31], s58 offen offset:1024 nt lds
    buffer_load_dwordx4 v10, s[28:31], s58 offen offset:2048 nt lds
    buffer_load_dwordx4 v11, s[28:31], s58 offen offset:3072 nt lds
    s_waitcnt vmcnt(20)
    s_or_b32 s55, s55, 45056
    s_add_u32 s55, s55, 4096
    s_andn2_b32 s55, s55, 45056
    s_mov_b32 m0, 81920
    s_nop 0
    buffer_load_dwordx4 v8, s[28:31], s55 offen offset:0 nt lds
    buffer_load_dwordx4 v9, s[28:31], s55 offen offset:1024 nt lds
    buffer_load_dwordx4 v10, s[28:31], s55 offen offset:2048 nt lds
    buffer_load_dwordx4 v11, s[28:31], s55 offen offset:3072 nt lds
    s_waitcnt vmcnt(20)
    s_mov_b32 m0, 86016
    s_add_u32 s58, s55, 4096
    buffer_load_dwordx4 v8, s[28:31], s58 offen offset:0 nt lds
    buffer_load_dwordx4 v9, s[28:31], s58 offen offset:1024 nt lds
    buffer_load_dwordx4 v10, s[28:31], s58 offen offset:2048 nt lds
    buffer_load_dwordx4 v11, s[28:31], s58 offen offset:3072 nt lds
    s_waitcnt vmcnt(20)
    s_barrier
    s_waitcnt vmcnt(20)
    s_mov_b32 m0, 90112
    s_add_u32 s58, s55, 8192
    buffer_load_dwordx4 v8, s[28:31], s58 offen offset:0 nt lds
    buffer_load_dwordx4 v9, s[28:31], s58 offen offset:1024 nt lds
    buffer_load_dwordx4 v10, s[28:31], s58 offen offset:2048 nt lds
    buffer_load_dwordx4 v11, s[28:31], s58 offen offset:3072 nt lds
    s_waitcnt vmcnt(20)
    s_mov_b32 m0, 94208
    s_add_u32 s58, s55, 12288
    buffer_load_dwordx4 v8, s[28:31], s58 offen offset:0 nt lds
    buffer_load_dwordx4 v9, s[28:31], s58 offen offset:1024 nt lds
    buffer_load_dwordx4 v10, s[28:31], s58 offen offset:2048 nt lds
    buffer_load_dwordx4 v11, s[28:31], s58 offen offset:3072 nt lds
    s_waitcnt vmcnt(16)
    s_barrier
    s_waitcnt vmcnt(0)
    s_barrier
L_end:
    s_endpgm
L_consumer:
    s_bfe_u32 s61, s2, 0x10003
    s_load_dwordx8 s[8:15], s[0:1], 24
    s_lshr_b32 s3, s52, 6
    s_sub_u32 s3, s3, 1
    s_and_b32 s62, s3, 3
    s_lshr_b32 s57, s3, 2
    v_lshrrev_b32 v2, 4, v1
    v_and_b32 v3, 15, v1
    v_xor_b32 v132, v2, v3
    v_lshlrev_b32 v132, 4, v132
    v_lshl_add_u32 v154, v3, 8, v132
    s_lshl_b32 s58, s62, 13
    v_add_u32 v12, s58, v154
    s_lshl_b32 s58, s57, 12
    v_add_u32 v144, s58, v154
    v_xor_b32 v13, 64, v12
    v_xor_b32 v145, 64, v144
    v_xor_b32 v14, 128, v12
    v_xor_b32 v146, 128, v144
    v_xor_b32 v15, 192, v12
    v_xor_b32 v147, 192, v144
    v_lshrrev_b32 v132, 2, v1
    v_bfe_u32 v135, v1, 3, 2
    v_lshlrev_b32 v135, 5, v135
    v_lshl_add_u32 v132, v132, 7, v135
    v_and_b32 v135, 3, v1
    v_lshl_add_u32 v20, v135, 3, v132
    s_lshl_b32 s58, s62, 12
    s_add_u32 s58, s58, 32768
    v_add_u32 v16, s58, v20
    v_xor_b32 v17, 32, v16
    v_xor_b32 v18, 64, v16
    v_xor_b32 v19, 96, v16
    s_mov_b32 s6, 0xffff
    s_mov_b32 s7, 0xffff
    v_lshlrev_b32 v132, 4, v1
    s_lshl_b32 s58, s62, 13
    s_lshl_b32 s59, s57, 12
    s_add_u32 s59, s59, 49152
    s_add_u32 s58, s58, s59
    v_add_u32 v149, s58, v132
    s_lshl_b32 s58, s62, 10
    s_add_u32 s59, s58, s59
    v_add_u32 v151, s59, v132
    s_lshl_b32 s59, s57, 12
    s_add_u32 s59, s59, 98304
    v_add_u32 v155, s59, v132
    v_add_u32 v150, s58, v155
    s_lshl_b32 s58, s57, 10
    s_add_u32 s58, s58, 147456
    v_lshlrev_b32 v152, 4, v3
    v_add_u32 v152, s58, v152
    s_lshl_b32 s58, s62, 8
    v_add_u32 v148, s58, v152
    s_lshl_b32 s58, s62, 5
    v_xor_b32 v23, s58, v20
    v_add_u32 v23, 32768, v23
    v_lshlrev_b32 v153, 3, v2
    v_lshl_add_u32 v153, v3, 8, v153
    s_lshl_b32 s16, s60, 13
    s_lshl_b32 s59, s61, 7
    s_add_u32 s16, s16, s59
    s_add_u32 s16, s16, s58
    s_lshl_b32 s59, s57, 12
    s_add_u32 s16, s16, s59
    v_mov_b32 v22, 0xf149f2ca
    v_mov_b32 v24, 0xefce03f9
    v_mov_b64 v[48:49], 0
    v_mov_b64 v[50:51], 0
    v_mov_b64 v[52:53], 0
    v_mov_b64 v[54:55], 0
    v_mov_b64 v[56:57], 0
    v_mov_b64 v[58:59], 0
    v_mov_b64 v[60:61], 0
    v_mov_b64 v[62:63], 0
    v_mov_b64 v[96:97], 0
    v_mov_b64 v[98:99], 0
    v_mov_b64 v[100:101], 0
    v_mov_b64 v[102:103], 0
    v_mov_b64 v[104:105], 0
    v_mov_b64 v[106:107], 0
    v_mov_b64 v[108:109], 0
    v_mov_b64 v[110:111], 0
    v_mov_b64 v[120:121], 0
    v_mov_b64 v[122:123], 0
    v_mov_b64 v[124:125], 0
    v_mov_b64 v[126:127], 0
    v_mov_b32 v128, 0x3f803f80
    v_mov_b32 v129, 0x3f803f80
    v_mov_b32 v130, 0x3f803f80
    v_mov_b32 v131, 0x3f803f80
    s_mov_b32 s22, 0x3e0293ee
    s_mov_b32 s23, 0x3e0293ee
    s_mov_b32 s53, 0
    s_mov_b32 s56, 0
    s_cmp_eq_u32 s62, 0
    s_cselect_b32 s17, 5, 15
    s_waitcnt lgkmcnt(0)
    s_mov_b32 s36, s14
    s_mov_b32 s37, s15
    s_mov_b32 s38, 0x100000
    s_mov_b32 s39, 0x20000
    s_barrier
    ds_read_b128 v[32:35], v144 offset:32768
    ds_read_b128 v[36:39], v145 offset:32768
    ds_read_b128 v[40:43], v146 offset:32768
    ds_read_b128 v[44:47], v147 offset:32768
    s_branch L_body
L_loop:
    s_barrier
L_body:
    ds_read_b128 v[64:67], v12 offset:0
    ds_read_b128 v[68:71], v13 offset:0
    ds_read_b128 v[72:75], v14 offset:0
    ds_read_b128 v[76:79], v15 offset:0
    ds_read_b128 v[80:83], v12 offset:4096
    ds_read_b128 v[84:87], v13 offset:4096
    ds_read_b128 v[88:91], v14 offset:4096
    ds_read_b128 v[92:95], v15 offset:4096
    s_add_u32 s56, s56, 49152
    s_cmp_eq_u32 s56, 147456
    s_cselect_b32 s56, 0, s56
    s_mov_b32 s59, 49152
    s_cselect_b32 s63, 0xfffe8000, s59
    s_add_u32 s53, s53, 1
    s_waitcnt lgkmcnt(7)
    v_mfma_f32_16x16x32_bf16 v[112:115], v[64:67], v[32:35], 0
    s_waitcnt lgkmcnt(6)
    v_mfma_f32_16x16x32_bf16 v[112:115], v[68:71], v[36:39], v[112:115]
    s_waitcnt lgkmcnt(5)
    v_mfma_f32_16x16x32_bf16 v[112:115], v[72:75], v[40:43], v[112:115]
    s_waitcnt lgkmcnt(4)
    v_mfma_f32_16x16x32_bf16 v[112:115], v[76:79], v[44:47], v[112:115]
    s_waitcnt lgkmcnt(3)
    v_mfma_f32_16x16x32_bf16 v[116:119], v[80:83], v[32:35], 0
    s_waitcnt lgkmcnt(2)
    v_mfma_f32_16x16x32_bf16 v[116:119], v[84:87], v[36:39], v[116:119]
    s_waitcnt lgkmcnt(1)
    v_mfma_f32_16x16x32_bf16 v[116:119], v[88:91], v[40:43], v[116:119]
    s_waitcnt lgkmcnt(0)
    v_mfma_f32_16x16x32_bf16 v[116:119], v[92:95], v[44:47], v[116:119]
    s_cmp_lt_u32 s53, 2
    s_cbranch_scc1 L_nov
    ds_read_b64_tr_b16 v[96:97], v16
    ds_read_b64_tr_b16 v[98:99], v16 offset:2048
    ds_read_b64_tr_b16 v[100:101], v17
    ds_read_b64_tr_b16 v[102:103], v17 offset:2048
    ds_read_b64_tr_b16 v[104:105], v18
    ds_read_b64_tr_b16 v[106:107], v18 offset:2048
    ds_read_b64_tr_b16 v[108:109], v19
    ds_read_b64_tr_b16 v[110:111], v19 offset:2048
L_nov:
    v_max3_f32 v132, v22, v112, v113
    v_max3_f32 v132, v132, v114, v115
    v_add_u32 v12, s63, v12
    v_add_u32 v13, s63, v13
    v_add_u32 v14, s63, v14
    v_add_u32 v15, s63, v15
    v_add_u32 v16, s63, v16
    v_add_u32 v17, s63, v17
    v_add_u32 v18, s63, v18
    v_add_u32 v19, s63, v19
    v_max3_f32 v132, v132, v116, v117
    v_max3_f32 v132, v132, v118, v119
    v_mov_b32 v133, v132
    v_mov_b32 v26, v24
    s_waitcnt lgkmcnt(0)
    v_permlane32_swap_b32 v132, v133
    v_max_f32 v132, v132, v133
    v_mov_b32 v133, v132
    v_mfma_f32_16x16x32_bf16 v[48:51], v[96:99], v[120:123], v[48:51]
    v_mfma_f32_16x16x32_bf16 v[52:55], v[100:103], v[120:123], v[52:55]
    v_permlane16_swap_b32 v132, v133
    v_max_f32 v22, v132, v133
    v_mul_f32 v24, s22, v22
    v_mfma_f32_16x16x32_bf16 v[56:59], v[104:107], v[120:123], v[56:59]
    v_sub_f32 v26, v26, v24
    v_pk_fma_f32 v[112:113], v[112:113], s[22:23], v[24:25] op_sel_hi:[1,1,0] neg_lo:[0,0,1] neg_hi:[0,0,1]
    v_pk_fma_f32 v[114:115], v[114:115], s[22:23], v[24:25] op_sel_hi:[1,1,0] neg_lo:[0,0,1] neg_hi:[0,0,1]
    v_pk_fma_f32 v[116:117], v[116:117], s[22:23], v[24:25] op_sel_hi:[1,1,0] neg_lo:[0,0,1] neg_hi:[0,0,1]
    v_pk_fma_f32 v[118:119], v[118:119], s[22:23], v[24:25] op_sel_hi:[1,1,0] neg_lo:[0,0,1] neg_hi:[0,0,1]
    s_nop 1
    v_mfma_f32_16x16x32_bf16 v[60:63], v[108:111], v[120:123], v[60:63]
    v_exp_f32 v26, v26
    v_exp_f32 v112, v112
    v_exp_f32 v113, v113
    v_exp_f32 v114, v114
    v_exp_f32 v115, v115
    v_exp_f32 v116, v116
    v_exp_f32 v117, v117
    v_exp_f32 v118, v118
    v_exp_f32 v119, v119
    v_cvt_pk_bf16_f32 v120, v112, v113
    v_cvt_pk_bf16_f32 v121, v114, v115
    v_cvt_pk_bf16_f32 v122, v116, v117
    v_cvt_pk_bf16_f32 v123, v118, v119
    v_mul_f32 v124, v124, v26
    v_pk_mul_f32 v[48:49], v[48:49], v[26:27] op_sel_hi:[1,0]
    v_pk_mul_f32 v[50:51], v[50:51], v[26:27] op_sel_hi:[1,0]
    s_nop 1
    v_mfma_f32_16x16x32_bf16 v[124:127], v[128:131], v[120:123], v[124:127]
    v_pk_mul_f32 v[52:53], v[52:53], v[26:27] op_sel_hi:[1,0]
    v_pk_mul_f32 v[54:55], v[54:55], v[26:27] op_sel_hi:[1,0]
    v_pk_mul_f32 v[56:57], v[56:57], v[26:27] op_sel_hi:[1,0]
    v_pk_mul_f32 v[58:59], v[58:59], v[26:27] op_sel_hi:[1,0]
    v_pk_mul_f32 v[60:61], v[60:61], v[26:27] op_sel_hi:[1,0]
    v_pk_mul_f32 v[62:63], v[62:63], v[26:27] op_sel_hi:[1,0]
L_skip:
    s_cmp_lt_u32 s53, s17
    s_cbranch_scc1 L_loop
    s_cmp_lt_u32 s53, 15
    s_cbranch_scc1 L_hook
    ds_write_b128 v150, v[120:123] offset:51200
    ds_write_b128 v149, v[48:51] offset:0
    ds_write_b128 v149, v[52:55] offset:1024
    ds_write_b128 v149, v[56:59] offset:2048
    ds_write_b128 v149, v[60:63] offset:3072
    s_waitcnt lgkmcnt(0)
    s_barrier
    ds_read_b128 v[64:67], v12 offset:0
    ds_read_b128 v[68:71], v13 offset:0
    ds_read_b128 v[72:75], v14 offset:0
    ds_read_b128 v[76:79], v15 offset:0
    ds_read_b128 v[80:83], v12 offset:4096
    ds_read_b128 v[84:87], v13 offset:4096
    ds_read_b128 v[88:91], v14 offset:4096
    ds_read_b128 v[92:95], v15 offset:4096
    s_waitcnt lgkmcnt(7)
    v_mfma_f32_16x16x32_bf16 v[112:115], v[64:67], v[32:35], 0
    s_waitcnt lgkmcnt(6)
    v_mfma_f32_16x16x32_bf16 v[112:115], v[68:71], v[36:39], v[112:115]
    s_waitcnt lgkmcnt(5)
    v_mfma_f32_16x16x32_bf16 v[112:115], v[72:75], v[40:43], v[112:115]
    s_waitcnt lgkmcnt(4)
    v_mfma_f32_16x16x32_bf16 v[112:115], v[76:79], v[44:47], v[112:115]
    s_waitcnt lgkmcnt(3)
    v_mfma_f32_16x16x32_bf16 v[116:119], v[80:83], v[32:35], 0
    s_waitcnt lgkmcnt(2)
    v_mfma_f32_16x16x32_bf16 v[116:119], v[84:87], v[36:39], v[116:119]
    s_waitcnt lgkmcnt(1)
    v_mfma_f32_16x16x32_bf16 v[116:119], v[88:91], v[40:43], v[116:119]
    s_waitcnt lgkmcnt(0)
    v_mfma_f32_16x16x32_bf16 v[116:119], v[92:95], v[44:47], v[116:119]
    v_max3_f32 v132, v22, v112, v113
    v_max3_f32 v132, v132, v114, v115
    v_mov_b32 v26, v24
    s_nop 4
    v_max3_f32 v132, v132, v116, v117
    v_max3_f32 v132, v132, v118, v119
    v_mov_b32 v133, v132
    s_nop 1
    v_permlane32_swap_b32 v132, v133
    v_max_f32 v132, v132, v133
    v_mov_b32 v133, v132
    s_nop 1
    v_permlane16_swap_b32 v132, v133
    v_max_f32 v22, v132, v133
    ds_read_b128 v[48:51], v151 offset:0
    ds_read_b128 v[52:55], v151 offset:8192
    ds_read_b128 v[56:59], v151 offset:16384
    ds_read_b128 v[60:63], v151 offset:24576
    ds_read_b128 v[64:67], v155 offset:51200
    ds_read_b128 v[68:71], v155 offset:52224
    ds_read_b128 v[72:75], v155 offset:53248
    ds_read_b128 v[76:79], v155 offset:54272
    v_mul_f32 v24, s22, v22
    v_sub_f32 v26, v26, v24
    v_pk_fma_f32 v[112:113], v[112:113], s[22:23], v[24:25] op_sel_hi:[1,1,0] neg_lo:[0,0,1] neg_hi:[0,0,1]
    v_pk_fma_f32 v[114:115], v[114:115], s[22:23], v[24:25] op_sel_hi:[1,1,0] neg_lo:[0,0,1] neg_hi:[0,0,1]
    v_pk_fma_f32 v[116:117], v[116:117], s[22:23], v[24:25] op_sel_hi:[1,1,0] neg_lo:[0,0,1] neg_hi:[0,0,1]
    v_pk_fma_f32 v[118:119], v[118:119], s[22:23], v[24:25] op_sel_hi:[1,1,0] neg_lo:[0,0,1] neg_hi:[0,0,1]
    v_exp_f32 v26, v26
    v_exp_f32 v112, v112
    v_exp_f32 v113, v113
    v_exp_f32 v114, v114
    v_exp_f32 v115, v115
    v_exp_f32 v116, v116
    v_exp_f32 v117, v117
    v_exp_f32 v118, v118
    v_exp_f32 v119, v119
    v_mul_f32 v124, v124, v26
    v_cvt_pk_bf16_f32 v120, v112, v113
    v_cvt_pk_bf16_f32 v121, v114, v115
    v_cvt_pk_bf16_f32 v122, v116, v117
    v_cvt_pk_bf16_f32 v123, v118, v119
    ds_write_b128 v150, v[120:123]
    s_nop 0
    v_mfma_f32_16x16x32_bf16 v[124:127], v[128:131], v[120:123], v[124:127]
    s_nop 7
    v_mov_b32 v25, v124
    ds_write_b128 v148, v[24:27]
    s_waitcnt lgkmcnt(0)
    s_barrier
    ds_read_b128 v[32:35], v152 offset:0
    ds_read_b128 v[36:39], v152 offset:256
    ds_read_b128 v[40:43], v152 offset:512
    ds_read_b128 v[44:47], v152 offset:768
    ds_read_b64_tr_b16 v[96:97], v23 offset:0
    ds_read_b64_tr_b16 v[98:99], v23 offset:2048
    ds_read_b64_tr_b16 v[100:101], v23 offset:4096
    ds_read_b64_tr_b16 v[102:103], v23 offset:6144
    ds_read_b64_tr_b16 v[104:105], v23 offset:8192
    ds_read_b64_tr_b16 v[106:107], v23 offset:10240
    ds_read_b64_tr_b16 v[108:109], v23 offset:12288
    ds_read_b64_tr_b16 v[110:111], v23 offset:14336
    s_waitcnt lgkmcnt(8)
    v_max3_f32 v132, v32, v36, v40
    v_max_f32 v132, v132, v44
    v_sub_f32 v32, v32, v132
    v_sub_f32 v36, v36, v132
    v_sub_f32 v40, v40, v132
    v_sub_f32 v44, v44, v132
    s_waitcnt lgkmcnt(6)
    v_mfma_f32_16x16x32_bf16 v[48:51], v[96:99], v[64:67], v[48:51]
    v_exp_f32 v32, v32
    s_waitcnt lgkmcnt(4)
    v_mfma_f32_16x16x32_bf16 v[52:55], v[100:103], v[68:71], v[52:55]
    v_exp_f32 v36, v36
    s_waitcnt lgkmcnt(2)
    v_mfma_f32_16x16x32_bf16 v[56:59], v[104:107], v[72:75], v[56:59]
    v_exp_f32 v40, v40
    s_waitcnt lgkmcnt(0)
    v_mfma_f32_16x16x32_bf16 v[60:63], v[108:111], v[76:79], v[60:63]
    v_exp_f32 v44, v44
    ds_read_b128 v[80:83], v155 offset:0
    ds_read_b128 v[84:87], v155 offset:1024
    ds_read_b128 v[88:91], v155 offset:2048
    ds_read_b128 v[92:95], v155 offset:3072
    v_mul_f32 v133, v32, v33
    v_fmac_f32 v133, v36, v37
    v_fmac_f32 v133, v40, v41
    v_fmac_f32 v133, v44, v45
    v_rcp_f32 v133, v133
    s_nop 0
    v_mul_f32 v32, v32, v133
    v_mul_f32 v36, v36, v133
    v_mul_f32 v40, v40, v133
    v_mul_f32 v44, v44, v133
    v_mul_f32 v34, v34, v32
    v_mul_f32 v38, v38, v36
    v_mul_f32 v42, v42, v40
    v_mul_f32 v46, v46, v44
    v_pk_mul_f32 v[136:137], v[48:49], v[34:35] op_sel_hi:[1,0]
    v_pk_mul_f32 v[138:139], v[50:51], v[34:35] op_sel_hi:[1,0]
    v_pk_fma_f32 v[136:137], v[52:53], v[38:39], v[136:137] op_sel_hi:[1,0,1]
    v_pk_fma_f32 v[138:139], v[54:55], v[38:39], v[138:139] op_sel_hi:[1,0,1]
    v_pk_fma_f32 v[136:137], v[56:57], v[42:43], v[136:137] op_sel_hi:[1,0,1]
    v_pk_fma_f32 v[138:139], v[58:59], v[42:43], v[138:139] op_sel_hi:[1,0,1]
    v_pk_fma_f32 v[136:137], v[60:61], v[46:47], v[136:137] op_sel_hi:[1,0,1]
    v_pk_fma_f32 v[138:139], v[62:63], v[46:47], v[138:139] op_sel_hi:[1,0,1]
    s_waitcnt lgkmcnt(0)
    s_barrier
    ds_read_b64_tr_b16 v[96:97], v23 offset:49152
    ds_read_b64_tr_b16 v[98:99], v23 offset:51200
    ds_read_b64_tr_b16 v[100:101], v23 offset:53248
    ds_read_b64_tr_b16 v[102:103], v23 offset:55296
    ds_read_b64_tr_b16 v[104:105], v23 offset:57344
    ds_read_b64_tr_b16 v[106:107], v23 offset:59392
    ds_read_b64_tr_b16 v[108:109], v23 offset:61440
    ds_read_b64_tr_b16 v[110:111], v23 offset:63488
    s_waitcnt lgkmcnt(6)
    v_mfma_f32_16x16x32_bf16 v[112:115], v[96:99], v[80:83], 0
    s_waitcnt lgkmcnt(4)
    v_mfma_f32_16x16x32_bf16 v[116:119], v[100:103], v[84:87], 0
    s_waitcnt lgkmcnt(2)
    v_mfma_f32_16x16x32_bf16 v[120:123], v[104:107], v[88:91], 0
    s_waitcnt lgkmcnt(0)
    v_mfma_f32_16x16x32_bf16 v[124:127], v[108:111], v[92:95], 0
    s_nop 1
    v_pk_fma_f32 v[136:137], v[112:113], v[32:33], v[136:137] op_sel_hi:[1,0,1]
    v_pk_fma_f32 v[138:139], v[114:115], v[32:33], v[138:139] op_sel_hi:[1,0,1]
    v_pk_fma_f32 v[136:137], v[116:117], v[36:37], v[136:137] op_sel_hi:[1,0,1]
    v_pk_fma_f32 v[138:139], v[118:119], v[36:37], v[138:139] op_sel_hi:[1,0,1]
    v_pk_fma_f32 v[136:137], v[120:121], v[40:41], v[136:137] op_sel_hi:[1,0,1]
    v_pk_fma_f32 v[138:139], v[122:123], v[40:41], v[138:139] op_sel_hi:[1,0,1]
    v_pk_fma_f32 v[136:137], v[124:125], v[44:45], v[136:137] op_sel_hi:[1,0,1]
    v_pk_fma_f32 v[138:139], v[126:127], v[44:45], v[138:139] op_sel_hi:[1,0,1]
    v_cvt_pk_bf16_f32 v52, v136, v137
    v_cvt_pk_bf16_f32 v53, v138, v139
    v_cvt_pk_bf16_f32 v54, v136, v137
    v_cvt_pk_bf16_f32 v55, v138, v139
    s_nop 0
    v_permlane16_swap_b32 v52, v54
    v_permlane16_swap_b32 v53, v55
    s_mov_b64 exec, s[6:7]
    buffer_store_dwordx4 v[52:55], v153, s[36:39], s16 offen
    s_endpgm
L_hook:
    s_cmp_eq_u32 s53, 6
    s_cbranch_scc1 L_tree_post
L_tree_pre:
    v_and_b32 v135, 7, v3
    v_and_b32 v136, 1, v2
    v_lshlrev_b32 v136, 3, v136
    v_lshl_add_u32 v135, v135, 4, v136
    v_add_u32 v135, 155648, v135
    ds_read_b64 v[30:31], v135
    s_waitcnt lgkmcnt(0)
    v_add_u32 v140, 149504, v154
    v_xor_b32 v141, 64, v140
    v_xor_b32 v142, 128, v140
    v_xor_b32 v143, 192, v140
    ds_read_b128 v[64:67], v140
    ds_read_b128 v[68:71], v141
    ds_read_b128 v[72:75], v142
    ds_read_b128 v[76:79], v143
    s_mov_b32 s58, 0xd028965f
    v_mov_b32 v134, 0xf149f2ca
    v_cmp_gt_u32 vcc, 2, v2
    v_lshlrev_b32 v136, 16, v30
    v_and_b32 v137, 0xffff0000, v30
    v_lshlrev_b32 v138, 16, v31
    v_and_b32 v139, 0xffff0000, v31
    v_sub_f32 v136, 1.0, v136
    v_mul_f32 v136, s58, v136
    v_sub_f32 v137, 1.0, v137
    v_mul_f32 v137, s58, v137
    v_sub_f32 v138, 1.0, v138
    v_mul_f32 v138, s58, v138
    v_sub_f32 v139, 1.0, v139
    v_mul_f32 v139, s58, v139
    s_waitcnt lgkmcnt(0)
    v_mfma_f32_16x16x32_bf16 v[156:159], v[64:67], v[32:35], 0
    v_mfma_f32_16x16x32_bf16 v[156:159], v[68:71], v[36:39], v[156:159]
    v_mfma_f32_16x16x32_bf16 v[156:159], v[72:75], v[40:43], v[156:159]
    v_mfma_f32_16x16x32_bf16 v[156:159], v[76:79], v[44:47], v[156:159]
    s_nop 7
    v_add_f32 v156, v156, v136
    v_add_f32 v157, v157, v137
    v_add_f32 v158, v158, v138
    v_add_f32 v159, v159, v139
    v_cndmask_b32 v156, v134, v156, vcc
    v_cndmask_b32 v157, v134, v157, vcc
    v_cndmask_b32 v158, v134, v158, vcc
    v_cndmask_b32 v159, v134, v159, vcc
    v_max3_f32 v22, v22, v156, v157
    v_max3_f32 v22, v22, v158, v159
    s_mov_b32 s17, 6
    s_branch L_loop
L_tree_post:
    v_add_u32 v140, 153600, v20
    ds_read_b64_tr_b16 v[96:97], v140
    v_xor_b32 v141, 32, v140
    ds_read_b64_tr_b16 v[100:101], v141
    v_xor_b32 v142, 64, v140
    ds_read_b64_tr_b16 v[104:105], v142
    v_xor_b32 v143, 96, v140
    ds_read_b64_tr_b16 v[108:109], v143
    v_cmp_gt_u32 vcc, 2, v2
    v_pk_fma_f32 v[156:157], v[156:157], s[22:23], v[24:25] op_sel_hi:[1,1,0] neg_lo:[0,0,1] neg_hi:[0,0,1]
    v_pk_fma_f32 v[158:159], v[158:159], s[22:23], v[24:25] op_sel_hi:[1,1,0] neg_lo:[0,0,1] neg_hi:[0,0,1]
    v_exp_f32 v156, v156
    v_exp_f32 v157, v157
    v_exp_f32 v158, v158
    v_exp_f32 v159, v159
    v_cvt_pk_bf16_f32 v136, v156, v157
    v_cvt_pk_bf16_f32 v137, v158, v159
    s_waitcnt lgkmcnt(0)
    v_cndmask_b32 v96, 0, v96, vcc
    v_cndmask_b32 v97, 0, v97, vcc
    v_cndmask_b32 v100, 0, v100, vcc
    v_cndmask_b32 v101, 0, v101, vcc
    v_cndmask_b32 v104, 0, v104, vcc
    v_cndmask_b32 v105, 0, v105, vcc
    v_cndmask_b32 v108, 0, v108, vcc
    v_cndmask_b32 v109, 0, v109, vcc
    v_mfma_f32_16x16x16_bf16 v[124:127], v[128:129], v[136:137], v[124:127]
    v_mfma_f32_16x16x16_bf16 v[48:51], v[96:97], v[136:137], v[48:51]
    v_mfma_f32_16x16x16_bf16 v[52:55], v[100:101], v[136:137], v[52:55]
    v_mfma_f32_16x16x16_bf16 v[56:59], v[104:105], v[136:137], v[56:59]
    v_mfma_f32_16x16x16_bf16 v[60:63], v[108:109], v[136:137], v[60:63]
    s_mov_b32 s17, 15
    s_branch L_loop
L_codeend:
.section .rodata,"a"
.p2align 6
.amdhsa_kernel standalone__tree_speculative_verify_tree_attention_over_candidate_token_tree__sampling_kernel
  .amdhsa_next_free_vgpr 160
  .amdhsa_next_free_sgpr 80
  .amdhsa_accum_offset 160
  .amdhsa_group_segment_fixed_size 0
  .amdhsa_kernarg_size 72
  .amdhsa_user_sgpr_count 2
  .amdhsa_user_sgpr_kernarg_segment_ptr 1
  .amdhsa_system_sgpr_workgroup_id_x 1
.end_amdhsa_kernel
```
